```python
import torch

def _softmax(x, axis=-1):
    return torch.softmax(x, dim=axis)
def _gelu(x):
    return torch.nn.functional.gelu(x, approximate="tanh")
def _silu(x):
    return torch.nn.functional.silu(x)
def _sigmoid(x):
    return torch.sigmoid(x)
def _layernorm(x, axis=-1, eps=1e-5):
    m = x.mean(dim=axis, keepdim=True)
    v = x.var(dim=axis, keepdim=True, unbiased=False)
    return (x - m) / torch.sqrt(v + eps)
def _scatter_add(tgt, idx, src, axis=0):
    return tgt.clone().index_add_(axis, idx, src)
def _segment_sum(src, seg, n):
    out = torch.zeros((n,) + src.shape[1:], dtype=src.dtype)
    return out.index_add_(0, seg, src)
def _pad(x, pw):
    flat = tuple(v for pair in reversed(pw) for v in pair)
    return torch.nn.functional.pad(x, flat)

kernel_name = 'standalone__paged_block_table_kv_radixattention__decode'

def setup_inputs():

    _w = (lambda a: (lambda t: t.to(torch.bfloat16) if t.is_floating_point() else t)(torch.as_tensor(a)))
    B, H, Hkv, Dh = 1, 32, 4, 128
    Lk = 65536
    bs = 16
    nb = max(2, Lk // bs)
    P = max(1, nb // 2)
    n_phys = P + B * (nb - P)
    shared = torch.arange(P, dtype=torch.int64)
    priv = P + torch.arange(B * (nb - P), dtype=torch.int64).reshape(B, nb - P)
    bt = torch.cat([torch.tile(shared[None, :], (B, 1)), priv], dim=1)
    ctx = nb * bs - (torch.arange(1, B + 1, dtype=torch.int64) * 2654435761) % max(1, (nb * bs - P * bs) // 2)
    return {
        "q": _w((lambda *s: torch.randn(*s, dtype=torch.bfloat16) * 0.8)(B, H, Dh)),
        "k_cache": _w((lambda *s: torch.randn(*s, dtype=torch.bfloat16) * 0.8)(n_phys, bs, Hkv, Dh)),
        "v_cache": _w((lambda *s: torch.randn(*s, dtype=torch.bfloat16) * 0.05)(n_phys, bs, Hkv, Dh)),
        "block_table": _w(bt.to(torch.int64)),
        "ctx_lens": _w(torch.as_tensor(ctx).to(torch.int64)),
    }

def reference(q, k_cache, v_cache, block_table, ctx_lens):
    B, H, Dh = q.shape
    n_phys, bs, Hkv, _ = k_cache.shape
    nb = block_table.shape[1]
    Lk = nb * bs
    rep = H // Hkv
    k = k_cache[block_table].reshape(B, Lk, Hkv, Dh)
    v = v_cache[block_table].reshape(B, Lk, Hkv, Dh)
    k = (lambda x, n, axis: torch.repeat_interleave(x, n, dim=axis))(k, rep, axis=2)
    v = (lambda x, n, axis: torch.repeat_interleave(x, n, dim=axis))(v, rep, axis=2)
    scores = torch.einsum("bhd,bkhd->bhk", q, k) * (Dh ** -0.5)
    pos = torch.arange(Lk)
    valid = pos[None, :] < ctx_lens[:, None]
    scores = torch.where(valid[:, None, :], scores, -1e9)
    p = _softmax(scores, axis=-1)
    return torch.einsum("bhk,bkhd->bhd", p, v)
```

```asm
; @launch grid=(256,1,1) block=(320,1,1) lds=78592
.amdgcn_target "amdgcn-amd-amdhsa--gfx950"
.text
.globl standalone__paged_block_table_kv_radixattention__decode_kernel
.p2align 12
.type standalone__paged_block_table_kv_radixattention__decode_kernel,@function
standalone__paged_block_table_kv_radixattention__decode_kernel:
    s_cmp_ge_u32 s2, 256
    s_cbranch_scc1 L_main_end
    s_load_dwordx16 s[64:79], s[0:1], 0
    v_lshrrev_b32 v1, 6, v0
    v_bfe_u32 v2, v0, 4, 2
    v_readfirstlane_b32 s36, v1
    v_and_b32 v1, 15, v0
    v_and_b32 v0, 63, v0
    s_cmp_ge_u32 s36, 4
    s_cbranch_scc1 L_sched
    s_bfe_u32 s55, s2, 0x10003
    s_lshr_b32 s59, s2, 4
    s_and_b32 s44, s2, 7
    s_lshl3_add_u32 s59, s59, s44
    s_cmp_ge_u32 s59, 128
    s_cselect_b32 s44, s55, 0
    s_sub_u32 s55, s55, s44
    s_mul_i32 s44, s44, 0
    s_add_u32 s59, s59, s44
    s_cmp_eq_u32 s55, 0
    s_cselect_b32 s62, 32, 32
    s_cselect_b32 s63, 4097, 4097
    s_cselect_b32 s63, s63, 4097
    s_lshl_b32 s62, s62, 2
    s_and_b32 s44, s36, 1
    s_lshl1_add_u32 s55, s55, s44
    s_lshr_b32 s58, s36, 1
    s_mul_i32 s58, s58, s62
    s_add_u32 s58, s58, s59
    s_lshl_b32 s62, s62, 1
    s_lshl_b32 s44, s55, 8
    s_mul_i32 s49, s36, 17152
    v_xor_b32 v29, v1, v2
    v_lshl_add_u32 v29, v29, 4, s44
    v_lshl_add_u32 v8, v2, 10, v29
    v_add_u32 v9, 3008, v8
    v_add_u32 v10, 6016, v8
    v_add_u32 v11, 9024, v8
    s_mov_b32 s18, 0x4000000
    s_mov_b32 s19, 0x00020000
    s_lshl_b32 s48, s58, 14
    s_mov_b32 m0, s49
    s_lshl_b32 s45, s55, 11
    v_lshl_add_u32 v24, v1, 8, s45
    v_lshl_add_u32 v24, v2, 4, v24
    v_and_b32 v29, 8, v1
    v_lshl_add_u32 v24, v29, 27, v24
    s_mov_b32 s26, 8192
    s_mov_b32 s27, s19
    s_add_u32 s44, s44, 128
    v_lshrrev_b32 v29, 1, v0
    v_and_b32 v29, 8, v29
    v_xor_b32 v29, v1, v29
    v_lshl_add_u32 v29, v29, 4, s44
    v_lshl_add_u32 v12, v2, 12, v29
    v_subrev_u32 v13, 32, v12
    v_subrev_u32 v14, 32, v13
    v_subrev_u32 v15, 32, v14
    s_mov_b32 s22, 0x4000080
    s_mov_b32 s23, s19
    s_add_u32 s51, s49, 4352
    s_waitcnt lgkmcnt(0)
    s_mov_b32 s16, s66
    s_and_b32 s17, s67, 0xffff
    buffer_load_dwordx4 v8, s[16:19], s48 offen offset:0 nt lds
    buffer_load_dwordx4 v9, s[16:19], s48 offen offset:1088 nt lds
    buffer_load_dwordx4 v10, s[16:19], s48 offen offset:2176 nt lds
    buffer_load_dwordx4 v11, s[16:19], s48 offen offset:3264 nt lds
    s_load_dword s37, s[72:73], 0
    s_mov_b32 s24, s64
    s_and_b32 s25, s65, 0xffff
    s_mov_b32 m0, s51
    buffer_load_dwordx4 v[48:51], v24, s[24:27], 0 offen offset:0
    buffer_load_dwordx4 v[52:55], v24, s[24:27], 0 offen offset:64
    buffer_load_dwordx4 v[56:59], v24, s[24:27], 0 offen offset:128
    buffer_load_dwordx4 v[60:63], v24, s[24:27], 0 offen offset:192
    s_sub_u32 s20, s68, 128
    s_subb_u32 s21, s69, 0
    s_and_b32 s21, s21, 0xffff
    s_add_u32 s51, s51, 4224
    buffer_load_dwordx4 v12, s[20:23], s48 offen offset:0 nt lds
    buffer_load_dwordx4 v13, s[20:23], s48 offen offset:1056 nt lds
    buffer_load_dwordx4 v14, s[20:23], s48 offen offset:2112 nt lds
    buffer_load_dwordx4 v15, s[20:23], s48 offen offset:3168 nt lds
    s_mov_b32 m0, s51
    s_add_u32 s51, s51, 4352
    s_lshl_b32 s3, s62, 14
    s_add_u32 s48, s48, s3
    buffer_load_dwordx4 v8, s[16:19], s48 offen offset:0 nt lds
    buffer_load_dwordx4 v9, s[16:19], s48 offen offset:1088 nt lds
    buffer_load_dwordx4 v10, s[16:19], s48 offen offset:2176 nt lds
    buffer_load_dwordx4 v11, s[16:19], s48 offen offset:3264 nt lds
    s_mov_b32 m0, s51
    s_add_u32 s51, s51, 4224
    s_nop 0
    buffer_load_dwordx4 v12, s[20:23], s48 offen offset:0 nt lds
    buffer_load_dwordx4 v13, s[20:23], s48 offen offset:1056 nt lds
    buffer_load_dwordx4 v14, s[20:23], s48 offen offset:2112 nt lds
    buffer_load_dwordx4 v15, s[20:23], s48 offen offset:3168 nt lds
    v_mul_u32_u24 v4, s62, v0
    v_add_u32 v4, s58, v4
    s_mov_b32 s32, s70
    s_and_b32 s33, s71, 0xffff
    v_lshlrev_b32 v5, 2, v4
    s_mov_b32 s34, 16384
    s_mov_b32 s35, s19
    buffer_load_dword v5, v5, s[32:35], 0 offen
    s_mov_b32 s28, s78
    s_and_b32 s29, s79, 0xffff
    s_mov_b32 s30, 0x10000000
    s_mov_b32 s31, s19
    s_lshl_b32 s44, s36, 2
    s_add_u32 s44, s44, 69120
    v_mov_b32 v6, s44
    v_lshrrev_b32 v29, 2, v1
    v_mul_u32_u24 v16, 1088, v29
    v_and_b32 v29, 3, v1
    v_lshl_add_u32 v16, v29, 8, v16
    v_xor_b32 v29, v29, v2
    v_lshl_add_u32 v16, v29, 4, v16
    v_add_u32 v16, s49, v16
    v_lshrrev_b32 v29, 2, v1
    v_mul_u32_u24 v17, 1056, v29
    v_lshl_add_u32 v17, v2, 8, v17
    v_and_b32 v29, 3, v1
    v_lshl_add_u32 v17, v29, 3, v17
    v_add_u32 v17, s49, v17
    v_add_u32 v17, 4352, v17
    v_and_b32 v29, 1, v2
    v_xor_b32 v30, 1, v29
    v_lshl_add_u32 v18, v30, 7, v17
    v_lshl_add_u32 v17, v29, 7, v17
    v_lshlrev_b32 v22, 2, v2
    s_mov_b32 s43, 0x3e0293ee
    v_mov_b32 v64, 0
    v_mov_b32 v65, 0
    v_mov_b32 v66, 0
    v_mov_b32 v67, 0
    v_mov_b32 v68, 0
    v_mov_b32 v69, 0
    v_mov_b32 v70, 0
    v_mov_b32 v71, 0
    v_mov_b32 v72, 0
    v_mov_b32 v73, 0
    v_mov_b32 v74, 0
    v_mov_b32 v75, 0
    v_mov_b32 v76, 0
    v_mov_b32 v77, 0
    v_mov_b32 v78, 0
    v_mov_b32 v79, 0
    v_mov_b32 v80, 0
    v_mov_b32 v81, 0
    v_mov_b32 v82, 0
    v_mov_b32 v83, 0
    v_mov_b32 v84, 0
    v_mov_b32 v85, 0
    v_mov_b32 v86, 0
    v_mov_b32 v87, 0
    v_mov_b32 v88, 0
    v_mov_b32 v89, 0
    v_mov_b32 v90, 0
    v_mov_b32 v91, 0
    v_mov_b32 v92, 0
    v_mov_b32 v93, 0
    v_mov_b32 v94, 0
    v_mov_b32 v95, 0
    v_mov_b32 v23, 0xff800000
    v_mov_b32 v26, 0xff800000
    v_mov_b32 v27, 0xff800000
    v_mov_b32 v28, 0
    v_bfrev_b32 v33, 1
    s_waitcnt lgkmcnt(0)
    s_mov_b32 s45, s37
    s_cmp_lt_i32 s37, 1
    s_cselect_b32 s37, 0x10000, s37
    s_min_u32 s37, s37, 0x10000
    s_add_u32 s38, s37, 15
    s_lshr_b32 s38, s38, 4
    s_add_u32 s56, s38, 0
    s_mul_i32 s56, s56, s63
    s_lshr_b32 s56, s56, 20
    s_sub_u32 s39, s38, 1
    s_lshl_b32 s40, s39, 4
    s_sub_u32 s40, s37, s40
    s_sub_u32 s54, s56, 2
    s_mul_i32 s57, s54, s62
    s_cmp_ge_u32 s56, 10
    s_cselect_b32 s57, s57, s38
    s_cselect_b32 s54, s54, 64
    s_cselect_b32 s44, 0x40000000, 0
    v_cmp_gt_u32 s[52:53], s57, v4
    v_cmp_eq_u32 vcc, s39, v4
    s_bcnt1_i32_b64 s41, s[52:53]
    s_or_b32 s41, s41, s44
    s_mov_b32 s46, 0
    s_mov_b32 s60, 2
    s_and_b64 vcc, vcc, s[52:53]
    s_ff1_i32_b64 s42, vcc
    v_lshlrev_b32 v3, 14, v4
    v_cndmask_b32 v3, v33, v3, s[52:53]
    s_lshl_b32 s44, s54, 3
    s_sub_u32 s44, 68608, s44
    s_and_b32 s3, s36, 2
    s_lshl1_add_u32 s44, s3, s44
    v_mov_b32 v7, s44
    s_mov_b32 s47, 0
    s_mov_b32 s50, 2
    s_cmp_gt_i32 s45, 0
    s_cbranch_scc1 L_qok
    s_waitcnt vmcnt(12)
    v_mov_b32 v48, 0
    v_mov_b32 v49, 0
    v_mov_b32 v50, 0
    v_mov_b32 v51, 0
    v_mov_b32 v52, 0
    v_mov_b32 v53, 0
    v_mov_b32 v54, 0
    v_mov_b32 v55, 0
    v_mov_b32 v56, 0
    v_mov_b32 v57, 0
    v_mov_b32 v58, 0
    v_mov_b32 v59, 0
    v_mov_b32 v60, 0
    v_mov_b32 v61, 0
    v_mov_b32 v62, 0
    v_mov_b32 v63, 0
L_qok:
    s_cmp_eq_u32 s41, 0
    s_cbranch_scc1 L_epi
.p2align 6
L_loop:
    s_cmp_eq_u32 s46, s60
    s_cbranch_scc1 L_verify
    v_add_u32 v19, s47, v16
    v_add_u32 v20, s47, v17
    v_add_u32 v21, s47, v18
    v_readlane_b32 s48, v3, s50
    v_mov_b32 v29, s46
    s_add_u32 s51, s49, s47
    s_mov_b64 exec, 1
    ds_write_b32 v6, v29
    s_mov_b64 exec, -1
    s_mov_b32 m0, s51
    s_cmp_ge_u32 s50, s54
    s_cbranch_scc1 L_dyn
L_dynret:
    s_waitcnt vmcnt(12)
    ds_read_b128 v[96:99], v19 offset:0
    ds_read_b128 v[100:103], v19 offset:64
    ds_read_b128 v[104:107], v19 offset:128
    ds_read_b128 v[108:111], v19 offset:192
    s_waitcnt lgkmcnt(3)
    v_mfma_f32_16x16x32_bf16 v[44:47], v[96:99], v[48:51], 0
    s_waitcnt lgkmcnt(2)
    v_mfma_f32_16x16x32_bf16 v[44:47], v[100:103], v[52:55], v[44:47]
    s_waitcnt lgkmcnt(1)
    v_mfma_f32_16x16x32_bf16 v[44:47], v[104:107], v[56:59], v[44:47]
    s_waitcnt lgkmcnt(0)
    v_mfma_f32_16x16x32_bf16 v[44:47], v[108:111], v[60:63], v[44:47]
    buffer_load_dwordx4 v8, s[16:19], s48 offen offset:0 nt lds
    buffer_load_dwordx4 v9, s[16:19], s48 offen offset:1088 nt lds
    buffer_load_dwordx4 v10, s[16:19], s48 offen offset:2176 nt lds
    buffer_load_dwordx4 v11, s[16:19], s48 offen offset:3264 nt lds
    s_add_u32 s51, s51, 4352
    s_waitcnt vmcnt(12)
    ds_read_b64_tr_b16 v[112:113], v20 offset:0
    ds_read_b64_tr_b16 v[114:115], v20 offset:32
    ds_read_b64_tr_b16 v[116:117], v20 offset:64
    ds_read_b64_tr_b16 v[118:119], v20 offset:96
    ds_read_b64_tr_b16 v[120:121], v21 offset:0
    ds_read_b64_tr_b16 v[122:123], v21 offset:32
    ds_read_b64_tr_b16 v[124:125], v21 offset:64
    ds_read_b64_tr_b16 v[126:127], v21 offset:96
    s_mov_b32 m0, s51
    s_cmp_lg_u32 s46, s42
    s_cbranch_scc1 L_nomask
    v_add_u32 v29, 0, v22
    v_cmp_gt_u32 vcc, s40, v29
    s_nop 1
    v_cndmask_b32 v44, v23, v44, vcc
    v_add_u32 v29, 1, v22
    v_cmp_gt_u32 vcc, s40, v29
    s_nop 1
    v_cndmask_b32 v45, v23, v45, vcc
    v_add_u32 v29, 2, v22
    v_cmp_gt_u32 vcc, s40, v29
    s_nop 1
    v_cndmask_b32 v46, v23, v46, vcc
    v_add_u32 v29, 3, v22
    v_cmp_gt_u32 vcc, s40, v29
    s_nop 1
    v_cndmask_b32 v47, v23, v47, vcc
L_nomask:
    v_max3_f32 v29, v44, v45, v46
    v_max3_f32 v29, v29, v47, v26
    v_mov_b32 v30, v29
    s_nop 1
    v_permlane32_swap_b32 v29, v30
    v_max_f32 v29, v29, v30
    v_mov_b32 v30, v29
    s_nop 1
    v_permlane16_swap_b32 v29, v30
    v_max_f32 v31, v29, v30
    v_cmp_gt_f32 vcc, v31, v26
    v_mul_f32 v32, s43, v31
    s_cbranch_vccz L_noresc
    v_sub_f32 v33, v27, v32
    v_exp_f32 v33, v33
    v_mov_b32 v26, v31
    v_mov_b32 v27, v32
    v_mul_f32 v28, v28, v33
    v_mul_f32 v64, v64, v33
    v_mul_f32 v65, v65, v33
    v_mul_f32 v66, v66, v33
    v_mul_f32 v67, v67, v33
    v_mul_f32 v68, v68, v33
    v_mul_f32 v69, v69, v33
    v_mul_f32 v70, v70, v33
    v_mul_f32 v71, v71, v33
    v_mul_f32 v72, v72, v33
    v_mul_f32 v73, v73, v33
    v_mul_f32 v74, v74, v33
    v_mul_f32 v75, v75, v33
    v_mul_f32 v76, v76, v33
    v_mul_f32 v77, v77, v33
    v_mul_f32 v78, v78, v33
    v_mul_f32 v79, v79, v33
    v_mul_f32 v80, v80, v33
    v_mul_f32 v81, v81, v33
    v_mul_f32 v82, v82, v33
    v_mul_f32 v83, v83, v33
    v_mul_f32 v84, v84, v33
    v_mul_f32 v85, v85, v33
    v_mul_f32 v86, v86, v33
    v_mul_f32 v87, v87, v33
    v_mul_f32 v88, v88, v33
    v_mul_f32 v89, v89, v33
    v_mul_f32 v90, v90, v33
    v_mul_f32 v91, v91, v33
    v_mul_f32 v92, v92, v33
    v_mul_f32 v93, v93, v33
    v_mul_f32 v94, v94, v33
    v_mul_f32 v95, v95, v33
L_noresc:
    v_fma_f32 v36, v44, s43, -v27
    v_fma_f32 v37, v45, s43, -v27
    v_fma_f32 v38, v46, s43, -v27
    v_fma_f32 v39, v47, s43, -v27
    v_exp_f32 v36, v36
    v_exp_f32 v37, v37
    v_exp_f32 v38, v38
    v_exp_f32 v39, v39
    s_nop 0
    v_cvt_pk_bf16_f32 v40, v36, v37
    v_cvt_pk_bf16_f32 v41, v38, v39
    v_add_f32 v29, v36, v37
    v_add_f32 v30, v38, v39
    s_waitcnt lgkmcnt(0)
    v_mfma_f32_16x16x16_bf16 v[64:67], v[112:113], v[40:41], v[64:67]
    v_mfma_f32_16x16x16_bf16 v[68:71], v[114:115], v[40:41], v[68:71]
    v_mfma_f32_16x16x16_bf16 v[72:75], v[116:117], v[40:41], v[72:75]
    v_mfma_f32_16x16x16_bf16 v[76:79], v[118:119], v[40:41], v[76:79]
    v_mfma_f32_16x16x16_bf16 v[80:83], v[120:121], v[40:41], v[80:83]
    v_mfma_f32_16x16x16_bf16 v[84:87], v[122:123], v[40:41], v[84:87]
    v_mfma_f32_16x16x16_bf16 v[88:91], v[124:125], v[40:41], v[88:91]
    v_mfma_f32_16x16x16_bf16 v[92:95], v[126:127], v[40:41], v[92:95]
L_skipc:
    s_waitcnt lgkmcnt(0)
    s_add_u32 s47, s47, 8576
    buffer_load_dwordx4 v12, s[20:23], s48 offen offset:0 nt lds
    buffer_load_dwordx4 v13, s[20:23], s48 offen offset:1056 nt lds
    buffer_load_dwordx4 v14, s[20:23], s48 offen offset:2112 nt lds
    buffer_load_dwordx4 v15, s[20:23], s48 offen offset:3168 nt lds
    v_add_f32 v29, v29, v30
    v_add_f32 v28, v28, v29
    s_cmp_eq_u32 s47, 17152
    s_cselect_b32 s47, 0, s47
    s_add_u32 s50, s50, 1
    s_add_u32 s46, s46, 1
    s_cmp_lt_u32 s46, s41
    s_cbranch_scc1 L_loop
L_epi:
    s_cmp_lg_u32 s60, -1
    s_cbranch_scc1 L_verify_wait
    s_cmp_eq_u32 s54, 64
    s_cbranch_scc1 L_clrw
L_clrok:
    v_mov_b32 v30, v28
    v_lshl_add_u32 v29, v2, 3, v1
    s_mul_i32 s44, s36, 2304
    v_permlane32_swap_b32 v28, v30
    v_add_f32 v28, v28, v30
    s_add_u32 s44, s44, 69376
    v_mov_b32 v30, v28
    v_lshl_add_u32 v19, v29, 4, s44
    v_lshl_add_u32 v21, v29, 3, s44
    v_permlane16_swap_b32 v28, v30
    s_mov_b32 s12, 0x00ff00ff
    s_mov_b32 s13, s12
    v_add_f32 v28, v28, v30
    v_max_f32 v27, 0xf149f2ca, v27
    s_mov_b64 exec, s[12:13]
    s_bitcmp1_b32 s36, 1
    s_cbranch_scc1 L_xw1
    ds_write_b128 v19, v[80:83] offset:0
    ds_write_b128 v19, v[84:87] offset:512
    ds_write_b128 v19, v[88:91] offset:1024
    ds_write_b128 v19, v[92:95] offset:1536
    s_mov_b32 s45, 4608
    s_branch L_xw2
L_xw1:
    ds_write_b128 v19, v[64:67] offset:0
    ds_write_b128 v19, v[68:71] offset:512
    ds_write_b128 v19, v[72:75] offset:1024
    ds_write_b128 v19, v[76:79] offset:1536
    s_mov_b32 s45, -4608
L_xw2:
    v_mov_b32 v26, v28
    v_mov_b32 v30, 1
    ds_write_b64 v21, v[26:27] offset:2048
    ds_write_b32 v6, v30 offset:32
    v_xor_b32 v30, 8, v6
    v_add_u32 v20, s45, v19
    v_add_u32 v21, s45, v21
L_xp:
    ds_read_b32 v29, v30 offset:32
    ds_read_b64 v[44:45], v21 offset:2048
    ds_read_b128 v[112:115], v20 offset:0
    ds_read_b128 v[116:119], v20 offset:512
    ds_read_b128 v[120:123], v20 offset:1024
    ds_read_b128 v[124:127], v20 offset:1536
    s_lshl_b32 s44, s55, 20
    s_lshl_b32 s45, s59, 10
    s_add_u32 s44, s44, s45
    s_and_b32 s45, s36, 2
    s_lshl_b32 s45, s45, 18
    s_add_u32 s44, s44, s45
    s_waitcnt lgkmcnt(5)
    v_readfirstlane_b32 s45, v29
    s_cbranch_execz L_xgo
    s_cmp_eq_u32 s45, 0
    s_cbranch_scc1 L_xp
L_xgo:
    s_mov_b64 exec, -1
    v_lshl_add_u32 v24, v0, 4, s44
    s_mov_b32 s44, 0x40000
    v_mov_b32 v99, v34
    v_mov_b32 v103, v34
    s_waitcnt lgkmcnt(4)
    v_max_f32 v31, v27, v45
    v_sub_f32 v36, v27, v31
    v_sub_f32 v38, v45, v31
    v_exp_f32 v36, v36
    v_exp_f32 v38, v38
    s_bitcmp1_b32 s36, 1
    v_mul_f32 v28, v28, v36
    v_fma_f32 v28, v44, v38, v28
    v_max_f32 v29, 0x00800000, v28
    v_rcp_f32 v29, v29
    v_log_f32 v42, v28
    v_mul_f32 v36, v36, v29
    v_mul_f32 v38, v38, v29
    v_add_f32 v42, v42, v31
    s_cbranch_scc1 L_xm1
    v_pk_mul_f32 v[48:49], v[64:65], v[36:37] op_sel_hi:[1,0]
    v_pk_mul_f32 v[50:51], v[66:67], v[36:37] op_sel_hi:[1,0]
    v_pk_mul_f32 v[52:53], v[68:69], v[36:37] op_sel_hi:[1,0]
    v_pk_mul_f32 v[54:55], v[70:71], v[36:37] op_sel_hi:[1,0]
    v_pk_mul_f32 v[56:57], v[72:73], v[36:37] op_sel_hi:[1,0]
    v_pk_mul_f32 v[58:59], v[74:75], v[36:37] op_sel_hi:[1,0]
    v_pk_mul_f32 v[60:61], v[76:77], v[36:37] op_sel_hi:[1,0]
    v_pk_mul_f32 v[62:63], v[78:79], v[36:37] op_sel_hi:[1,0]
    s_branch L_xm2
L_xm1:
    v_pk_mul_f32 v[48:49], v[80:81], v[36:37] op_sel_hi:[1,0]
    v_pk_mul_f32 v[50:51], v[82:83], v[36:37] op_sel_hi:[1,0]
    v_pk_mul_f32 v[52:53], v[84:85], v[36:37] op_sel_hi:[1,0]
    v_pk_mul_f32 v[54:55], v[86:87], v[36:37] op_sel_hi:[1,0]
    v_pk_mul_f32 v[56:57], v[88:89], v[36:37] op_sel_hi:[1,0]
    v_pk_mul_f32 v[58:59], v[90:91], v[36:37] op_sel_hi:[1,0]
    v_pk_mul_f32 v[60:61], v[92:93], v[36:37] op_sel_hi:[1,0]
    v_pk_mul_f32 v[62:63], v[94:95], v[36:37] op_sel_hi:[1,0]
L_xm2:
    v_max_f32 v42, 0xf149f2ca, v42
    s_waitcnt lgkmcnt(0)
    v_pk_fma_f32 v[56:57], v[120:121], v[38:39], v[56:57] op_sel_hi:[1,0,1]
    v_pk_fma_f32 v[58:59], v[122:123], v[38:39], v[58:59] op_sel_hi:[1,0,1]
    v_pk_fma_f32 v[48:49], v[112:113], v[38:39], v[48:49] op_sel_hi:[1,0,1]
    v_pk_fma_f32 v[50:51], v[114:115], v[38:39], v[50:51] op_sel_hi:[1,0,1]
    v_mov_b32_dpp v42, v42 row_shr:8 row_mask:0xf bank_mask:0xc
    v_cvt_pk_bf16_f32 v104, v56, v57
    v_cvt_pk_bf16_f32 v105, v58, v59
    v_cvt_pk_bf16_f32 v96, v48, v49
    v_cvt_pk_bf16_f32 v97, v50, v51
    v_mov_b32 v98, v42
    v_mov_b32_dpp v96, v104 row_shr:8 row_mask:0xf bank_mask:0xc
    v_mov_b32_dpp v97, v105 row_shr:8 row_mask:0xf bank_mask:0xc
    v_pk_fma_f32 v[60:61], v[124:125], v[38:39], v[60:61] op_sel_hi:[1,0,1]
    v_pk_fma_f32 v[62:63], v[126:127], v[38:39], v[62:63] op_sel_hi:[1,0,1]
    buffer_store_dwordx4 v[96:99], v24, s[28:31], 0 offen sc1
    v_pk_fma_f32 v[52:53], v[116:117], v[38:39], v[52:53] op_sel_hi:[1,0,1]
    v_pk_fma_f32 v[54:55], v[118:119], v[38:39], v[54:55] op_sel_hi:[1,0,1]
    v_cvt_pk_bf16_f32 v106, v60, v61
    v_cvt_pk_bf16_f32 v107, v62, v63
    v_cvt_pk_bf16_f32 v100, v52, v53
    v_cvt_pk_bf16_f32 v101, v54, v55
    v_mov_b32 v102, v42
    v_mov_b32_dpp v100, v106 row_shr:8 row_mask:0xf bank_mask:0xc
    v_mov_b32_dpp v101, v107 row_shr:8 row_mask:0xf bank_mask:0xc
    buffer_store_dwordx4 v[100:103], v24, s[28:31], s44 offen sc1
    v_bfrev_b32 v29, -2
    ds_write_b32 v6, v29
    s_lshr_b32 s6, s2, 4
    s_and_b32 s4, s2, 7
    s_lshl_b32 s4, s4, 1
    s_bfe_u32 s5, s2, 0x10003
    s_or_b32 s4, s4, s5
    s_lshl_b32 s7, s6, 18
    s_lshl_b32 s8, s4, 6
    s_add_u32 s7, s7, s8
    s_cmp_lt_u32 s2, 128
    s_cselect_b32 s13, 32, 32
    s_mul_i32 s8, s36, s13
    s_lshl_b32 s8, s8, 10
    s_add_u32 s7, s7, s8
    v_lshrrev_b32 v29, 2, v0
    v_and_b32 v30, 3, v0
    v_lshl_add_u32 v25, v30, 4, s7
    v_mul_u32_u24 v29, 3, v29
    v_lshl_add_u32 v25, v29, 10, v25
    v_sub_u32 v33, s13, v29
    s_lshr_b32 s9, s2, 6
    s_lshl_b32 s9, s9, 11
    s_and_b32 s8, s4, 1
    s_lshl_b32 s8, s8, 10
    s_add_u32 s9, s9, s8
    s_and_b32 s8, s6, 1
    s_lshl_b32 s8, s8, 5
    s_add_u32 s9, s9, s8
    s_and_b32 s8, s6, 2
    s_lshl_b32 s8, s8, 6
    s_add_u32 s9, s9, s8
    s_and_b32 s8, s4, 2
    s_lshl_b32 s8, s8, 5
    s_add_u32 s9, s9, s8
    s_lshr_b32 s8, s4, 2
    s_lshl_b32 s8, s8, 3
    s_add_u32 s9, s9, s8
    v_lshl_add_u32 v35, v30, 8, s9
    v_lshrrev_b32 v29, 5, v0
    v_lshl_add_u32 v35, v29, 2, v35
    v_lshl_add_u32 v43, v29, 2, v30
    v_lshlrev_b32 v43, 4, v43
    s_mov_b32 s32, s74
    s_and_b32 s33, s75, 0xffff
    s_mov_b32 s34, 8192
    s_mov_b32 s35, 0x00020000
    v_cmp_lt_i32 s[4:5], 0, v33
    v_cmp_lt_i32 s[6:7], 1, v33
    v_cmp_lt_i32 s[8:9], 2, v33
    s_mov_b32 s14, 15
    s_mov_b32 s15, 15
    v_mov_b32 v64, 0
    v_mov_b32 v65, 0
    v_mov_b32 v66, 0xf149f2ca
    v_mov_b32 v67, v34
    v_mov_b32 v68, 0
    v_mov_b32 v69, 0
    v_mov_b32 v70, 0xf149f2ca
    v_mov_b32 v71, v34
    v_mov_b32 v72, 0
    v_mov_b32 v73, 0
    v_mov_b32 v74, 0xf149f2ca
    v_mov_b32 v75, v34
    s_waitcnt vmcnt(0)
    s_mov_b64 exec, s[4:5]
    buffer_load_dwordx4 v[64:67], v25, s[28:31], 0 offen offset:0 sc1
    s_mov_b64 exec, s[6:7]
    buffer_load_dwordx4 v[68:71], v25, s[28:31], 0 offen offset:1024 sc1
    s_mov_b64 exec, s[8:9]
    buffer_load_dwordx4 v[72:75], v25, s[28:31], 0 offen offset:2048 sc1
    s_mov_b64 exec, -1
    v_readfirstlane_b32 s61, v34
    v_mov_b32 v123, 0xffff0000
    v_mov_b32 v29, 69140
    v_mov_b32 v30, 1
    v_add_u32 v24, s49, v43
    s_branch L_c1w
L_c1:
    s_mov_b64 exec, s[4:5]
    s_cbranch_execz L_c1s0
    buffer_load_dwordx4 v[64:67], v25, s[28:31], 0 offen offset:0 sc1
L_c1s0:
    s_mov_b64 exec, s[6:7]
    s_cbranch_execz L_c1s1
    buffer_load_dwordx4 v[68:71], v25, s[28:31], 0 offen offset:1024 sc1
L_c1s1:
    s_mov_b64 exec, s[8:9]
    s_cbranch_execz L_c1s2
    buffer_load_dwordx4 v[72:75], v25, s[28:31], 0 offen offset:2048 sc1
L_c1s2:
    s_mov_b64 exec, -1
L_c1w:
    s_waitcnt vmcnt(0)
    v_cmp_ne_u32 s[4:5], s61, v67
    v_cmp_ne_u32 s[6:7], s61, v71
    v_cmp_ne_u32 s[8:9], s61, v75
    s_or_b64 s[12:13], s[4:5], s[6:7]
    s_or_b64 s[12:13], s[12:13], s[8:9]
    s_cbranch_scc1 L_c1
L_cmath:
    v_max3_f32 v112, v66, v70, v74
    v_lshlrev_b32 v96, 16, v64
    v_and_b32 v97, v123, v64
    v_lshlrev_b32 v98, 16, v65
    v_and_b32 v99, v123, v65
    v_max_f32_dpp v112, v112, v112 row_ror:4 row_mask:0xf bank_mask:0xf
    v_lshlrev_b32 v100, 16, v68
    v_and_b32 v101, v123, v68
    v_lshlrev_b32 v102, 16, v69
    v_and_b32 v103, v123, v69
    v_max_f32_dpp v112, v112, v112 row_ror:8 row_mask:0xf bank_mask:0xf
    v_mov_b32 v122, v112
    v_lshlrev_b32 v104, 16, v72
    v_and_b32 v105, v123, v72
    v_lshlrev_b32 v106, 16, v73
    v_and_b32 v107, v123, v73
    v_permlane16_swap_b32 v112, v122
    v_max_f32 v112, v112, v122
    v_mov_b32 v122, v112
    s_nop 1
    v_permlane32_swap_b32 v112, v122
    v_max_f32 v112, v112, v122
    v_sub_f32 v66, v66, v112
    v_sub_f32 v70, v70, v112
    v_sub_f32 v74, v74, v112
    v_exp_f32 v66, v66
    v_exp_f32 v70, v70
    v_exp_f32 v74, v74
    s_nop 0
    v_pk_mul_f32 v[114:115], v[96:97], v[66:67] op_sel_hi:[1,0]
    v_pk_mul_f32 v[116:117], v[98:99], v[66:67] op_sel_hi:[1,0]
    v_add_f32 v113, v66, v70
    v_pk_fma_f32 v[114:115], v[100:101], v[70:71], v[114:115] op_sel_hi:[1,0,1]
    v_pk_fma_f32 v[116:117], v[102:103], v[70:71], v[116:117] op_sel_hi:[1,0,1]
    v_add_f32 v113, v113, v74
    v_pk_fma_f32 v[114:115], v[104:105], v[74:75], v[114:115] op_sel_hi:[1,0,1]
    v_pk_fma_f32 v[116:117], v[106:107], v[74:75], v[116:117] op_sel_hi:[1,0,1]
    v_mov_b32 v122, v113
    s_nop 0
    v_permlane32_swap_b32 v114, v116
    v_permlane32_swap_b32 v115, v117
    v_permlane32_swap_b32 v113, v122
    v_pk_add_f32 v[114:115], v[114:115], v[116:117]
    v_add_f32 v113, v113, v122
    v_pk_mov_b32 v[116:117], v[114:115], v[114:115] op_sel:[0,1]
    v_mov_b32 v122, v113
    s_nop 0
    v_permlane16_swap_b32 v114, v116
    v_permlane16_swap_b32 v115, v117
    v_permlane16_swap_b32 v113, v122
    v_pk_add_f32 v[114:115], v[114:115], v[116:117]
    v_add_f32 v113, v113, v122
    s_nop 0
    v_add_f32_dpp v114, v114, v114 row_ror:4 row_mask:0xf bank_mask:0xf
    v_add_f32_dpp v115, v115, v115 row_ror:4 row_mask:0xf bank_mask:0xf
    v_add_f32_dpp v113, v113, v113 row_ror:4 row_mask:0xf bank_mask:0xf
    s_nop 0
    v_add_f32_dpp v114, v114, v114 row_ror:8 row_mask:0xf bank_mask:0xf
    v_add_f32_dpp v115, v115, v115 row_ror:8 row_mask:0xf bank_mask:0xf
    v_add_f32_dpp v113, v113, v113 row_ror:8 row_mask:0xf bank_mask:0xf
    s_mov_b64 exec, s[14:15]
    ds_write_b128 v24, v[112:115] offset:8192
    s_and_b64 exec, exec, 1
    ds_add_rtn_u32 v122, v29, v30
    s_mov_b64 exec, s[14:15]
    ds_read_b128 v[96:99], v43 offset:8192
    ds_read_b128 v[100:103], v43 offset:25344
    ds_read_b128 v[104:107], v43 offset:42496
    ds_read_b128 v[108:111], v43 offset:59648
    s_waitcnt lgkmcnt(4)
    v_readfirstlane_b32 s12, v122
    s_cbranch_execz L_cmerge
    s_cmp_lg_u32 s12, 3
    s_cbranch_scc1 L_main_end
L_cmerge:
    s_waitcnt lgkmcnt(0)
    v_max3_f32 v112, v96, v100, v104
    v_max_f32 v112, v112, v108
    v_sub_f32 v96, v96, v112
    v_sub_f32 v100, v100, v112
    v_sub_f32 v104, v104, v112
    v_sub_f32 v108, v108, v112
    v_exp_f32 v96, v96
    v_exp_f32 v100, v100
    v_exp_f32 v104, v104
    v_exp_f32 v108, v108
    v_mul_f32 v113, v97, v96
    v_fma_f32 v113, v101, v100, v113
    v_fma_f32 v113, v105, v104, v113
    v_fma_f32 v113, v109, v108, v113
    v_rcp_f32 v116, v113
    v_pk_mul_f32 v[114:115], v[98:99], v[96:97] op_sel_hi:[1,0]
    v_pk_fma_f32 v[114:115], v[102:103], v[100:101], v[114:115] op_sel_hi:[1,0,1]
    v_pk_fma_f32 v[114:115], v[106:107], v[104:105], v[114:115] op_sel_hi:[1,0,1]
    v_pk_fma_f32 v[114:115], v[110:111], v[108:109], v[114:115] op_sel_hi:[1,0,1]
    v_pk_mul_f32 v[114:115], v[114:115], v[116:117] op_sel_hi:[1,0]
    s_cbranch_execz L_swarm0
    v_cvt_pk_bf16_f32 v114, v114, v115
    buffer_store_dword v114, v35, s[32:35], 0 offen
L_main_end:
    s_endpgm
L_clrw:
    v_mov_b32 v30, 69136
L_clrw2:
    ds_read_b32 v34, v30
    s_waitcnt lgkmcnt(0)
    v_readfirstlane_b32 s44, v34
    s_cmp_lg_u32 s44, 0
    s_cbranch_scc1 L_clrok
    s_sleep 1
    s_branch L_clrw2
L_dyn:
    s_brev_b32 s48, 1
    s_cmp_ge_u32 s50, s41
    s_cbranch_scc1 L_dynret
    v_lshl_add_u32 v30, s50, 3, v7
L_poll:
    ds_read_b32 v29, v30
    s_waitcnt lgkmcnt(0)
    v_readfirstlane_b32 s48, v29
    s_cmp_lg_u32 s48, -1
    s_cbranch_scc1 L_got
    s_sleep 1
    s_branch L_poll
L_got:
    v_mov_b32 v30, 69136
    ds_read_b32 v34, v30
    s_cmp_lt_i32 s48, 0
    s_cselect_b32 s41, s50, s41
    s_bitcmp1_b32 s48, 0
    s_cselect_b32 s42, s50, s42
    s_andn2_b32 s48, s48, 1
    s_branch L_dynret
L_sched:
    s_setprio 3
    v_lshlrev_b32 v1, 2, v0
    v_add_u32 v1, 68608, v1
    v_mov_b32 v12, -1
    v_mov_b32 v3, 0
    ds_write_b32 v1, v12
    ds_write_b32 v1, v12 offset:256
    ds_write_b32 v1, v3 offset:512
    s_lshr_b32 s3, s2, 3
    s_and_b32 s3, s3, 15
    s_and_b32 s18, s3, 3
    s_lshr_b32 s4, s2, 4
    s_and_b32 s5, s2, 7
    s_lshl3_add_u32 s4, s4, s5
    s_lshr_b32 s5, s4, 3
    s_add_u32 s5, s5, s4
    s_and_b32 s5, s5, 7
    s_and_b32 s3, s3, 1
    s_cmp_ge_u32 s4, 128
    s_cselect_b32 s17, s3, 0
    s_cselect_b32 s3, 0, s3
    s_mul_i32 s17, s17, 0
    s_add_u32 s17, s17, s4
    s_lshl_b32 s17, s17, 10
    s_lshl_b32 s16, s3, 21
    s_add_u32 s16, s16, s17
    s_lshl1_add_u32 s3, s5, s3
    s_bitcmp0_b32 s3, 0
    s_cselect_b32 s4, 32, 32
    s_cselect_b32 s5, 4097, 4097
    s_cselect_b32 s5, s5, 4097
    s_lshl_b32 s4, s4, 3
    s_lshl_b32 s19, s18, 6
    s_mov_b32 s22, 16384
    s_mov_b32 s23, 0x00020000
    s_mov_b32 s26, 256
    s_mov_b32 s27, 0x00020000
    s_mov_b32 s30, 0x10000000
    s_mov_b32 s31, 0x00020000
    s_mov_b32 s34, 8192
    s_mov_b32 s35, 0x00020000
    v_mov_b32 v4, s19
    s_waitcnt lgkmcnt(0)
    s_load_dword s37, s[72:73], 0
    s_mov_b32 s28, s78
    s_and_b32 s29, s79, 0xffff
    s_mov_b32 s24, s76
    s_and_b32 s25, s77, 0xffff
    s_cmp_lg_u32 s2, 0
    s_cbranch_scc1 L_snoinit
    s_memrealtime s[44:45]
    v_lshlrev_b32 v8, 8, v0
    v_add_u32 v8, 0x800000, v8
    v_mov_b32 v9, 0
    v_lshlrev_b32 v11, 6, v0
    s_mov_b64 exec, 65535
    buffer_atomic_swap v9, v8, s[28:31], 0 offen sc0 sc1
    s_waitcnt lgkmcnt(0)
    s_mul_i32 s44, s44, 0x9e3779b1
    s_mul_i32 s45, s45, 0xc2b2ae35
    s_lshr_b32 s46, s44, 15
    s_xor_b32 s44, s44, s46
    s_mul_i32 s44, s44, 0x85ebca6b
    s_add_u32 s44, s44, s45
    s_max_u32 s44, s44, 1
    v_mov_b32 v5, s44
    s_mov_b64 exec, 15
    s_waitcnt vmcnt(0)
    buffer_atomic_or v5, v11, s[24:27], 0 offen sc1
    s_mov_b64 exec, -1
L_snoinit:
    s_mov_b32 s20, s70
    s_and_b32 s21, s71, 0xffff
    s_mov_b32 s32, s74
    s_and_b32 s33, s75, 0xffff
    s_waitcnt lgkmcnt(0)
    s_cmp_lt_i32 s37, 1
    s_cselect_b32 s37, 0x10000, s37
    s_min_u32 s37, s37, 0x10000
    s_add_u32 s38, s37, 15
    s_lshr_b32 s38, s38, 4
    s_add_u32 s39, s38, 0
    s_mul_i32 s39, s39, s5
    s_lshr_b32 s39, s39, 20
    s_sub_u32 s40, s39, 2
    s_mul_i32 s41, s40, s4
    s_lshr_b32 s42, s3, 1
    s_add_u32 s41, s41, s42
    v_lshl_add_u32 v6, v0, 4, s41
    v_lshlrev_b32 v10, 2, v6
    buffer_load_dword v7, v10, s[20:23], 0 offen
    buffer_load_dword v9, v10, s[20:23], 0 offen offset:32
    s_sub_u32 s42, s38, 1
    v_bfrev_b32 v11, 1
    s_waitcnt vmcnt(0)
    v_cmp_gt_u32 s[44:45], s38, v6
    v_cmp_eq_u32 s[46:47], s42, v6
    v_cmp_gt_i32 vcc, 0, v7
    v_add_u32 v10, 4096, v7
    v_add_u32 v6, 8, v6
    v_cndmask_b32 v7, v7, v10, vcc
    v_lshlrev_b32 v7, 14, v7
    v_or_b32 v10, 1, v7
    v_cndmask_b32 v7, v7, v10, s[46:47]
    v_and_b32 v7, 0x7fffffff, v7
    v_cndmask_b32 v7, v11, v7, s[44:45]
    v_cmp_gt_u32 s[44:45], s38, v6
    v_cmp_eq_u32 s[46:47], s42, v6
    v_cmp_gt_i32 vcc, 0, v9
    v_add_u32 v10, 4096, v9
    v_add_u32 v6, 8, v6
    v_cndmask_b32 v9, v9, v10, vcc
    v_lshlrev_b32 v9, 14, v9
    v_or_b32 v10, 1, v9
    v_cndmask_b32 v9, v9, v10, s[46:47]
    v_and_b32 v9, 0x7fffffff, v9
    v_cndmask_b32 v9, v11, v9, s[44:45]
    s_lshl_b32 s43, s3, 8
    s_add_u32 s43, s43, 0x800000
    v_mov_b32 v8, s43
    v_mov_b32 v1, 69120
    v_mov_b32 v3, 68608
    s_sub_u32 s49, s40, 3
    s_barrier
    v_mov_b32 v122, 3
    s_mov_b64 s[14:15], 0
    s_mov_b64 exec, 0
    s_branch L_cmath
L_swarm0:
L_swarm:
    s_mov_b64 exec, 1
    s_branch L_sflag
L_sflagw:
    s_sleep 16
L_sflag:
    buffer_load_dword v5, v4, s[24:27], 0 offen sc1
    s_waitcnt vmcnt(0)
    v_readfirstlane_b32 s61, v5
    s_cmp_eq_u32 s61, 0
    s_cbranch_scc1 L_sflagw
    ds_write_b32 v1, v5 offset:16
    s_cmp_ge_u32 s39, 10
    s_cbranch_scc0 L_sown
    s_branch L_sloop
L_swait:
    s_sleep 1
L_sloop:
    ds_read_b128 v[12:15], v1
    v_mov_b32 v5, 1
    s_waitcnt lgkmcnt(0)
    v_max3_u32 v12, v12, v13, v14
    v_max_u32 v12, v12, v15
    s_nop 0
    v_readfirstlane_b32 s48, v12
    s_cmp_lt_u32 s48, s49
    s_cbranch_scc1 L_swait
    buffer_atomic_add v5, v8, s[28:31], 0 offen sc0 sc1
    s_add_u32 s49, s49, 1
    s_waitcnt vmcnt(0)
    v_readfirstlane_b32 s48, v5
    s_min_u32 s48, s48, 63
    s_nop 3
    v_readlane_b32 s50, v7, s48
    v_readlane_b32 s51, v9, s48
    s_nop 1
    v_mov_b32 v16, s50
    v_mov_b32 v17, s51
    ds_write_b64 v3, v[16:17]
    v_add_u32 v3, 8, v3
    s_cmp_lt_i32 s50, 0
    s_cbranch_scc0 L_sloop
L_sown:
    s_endpgm
L_verify_wait:
    s_waitcnt vmcnt(0)
L_verify:
    v_bfrev_b32 v30, 1
    s_mov_b32 s60, -1
    s_barrier
    v_cmp_gt_i32 vcc, 0, v5
    v_add_u32 v29, 4096, v5
    s_nop 0
    v_cndmask_b32 v5, v5, v29, vcc
    v_lshlrev_b32 v5, 14, v5
    v_cndmask_b32 v5, v30, v5, s[52:53]
    v_cmp_ne_u32 vcc, v5, v3
    s_cbranch_vccnz L_restart
    s_cmp_lt_u32 s46, s41
    s_cbranch_scc1 L_loop
    s_branch L_epi
L_restart:
    s_waitcnt vmcnt(0) lgkmcnt(0)
    s_nop 7
    s_nop 7
    v_mov_b32 v3, v5
    v_mov_b32 v64, 0
    v_mov_b32 v65, 0
    v_mov_b32 v66, 0
    v_mov_b32 v67, 0
    v_mov_b32 v68, 0
    v_mov_b32 v69, 0
    v_mov_b32 v70, 0
    v_mov_b32 v71, 0
    v_mov_b32 v72, 0
    v_mov_b32 v73, 0
    v_mov_b32 v74, 0
    v_mov_b32 v75, 0
    v_mov_b32 v76, 0
    v_mov_b32 v77, 0
    v_mov_b32 v78, 0
    v_mov_b32 v79, 0
    v_mov_b32 v80, 0
    v_mov_b32 v81, 0
    v_mov_b32 v82, 0
    v_mov_b32 v83, 0
    v_mov_b32 v84, 0
    v_mov_b32 v85, 0
    v_mov_b32 v86, 0
    v_mov_b32 v87, 0
    v_mov_b32 v88, 0
    v_mov_b32 v89, 0
    v_mov_b32 v90, 0
    v_mov_b32 v91, 0
    v_mov_b32 v92, 0
    v_mov_b32 v93, 0
    v_mov_b32 v94, 0
    v_mov_b32 v95, 0
    v_mov_b32 v26, 0xff800000
    v_mov_b32 v27, 0xff800000
    v_mov_b32 v28, 0
    s_cmp_gt_i32 s45, 0
    s_cbranch_scc1 L_qok2
    v_mov_b32 v48, 0
    v_mov_b32 v49, 0
    v_mov_b32 v50, 0
    v_mov_b32 v51, 0
    v_mov_b32 v52, 0
    v_mov_b32 v53, 0
    v_mov_b32 v54, 0
    v_mov_b32 v55, 0
    v_mov_b32 v56, 0
    v_mov_b32 v57, 0
    v_mov_b32 v58, 0
    v_mov_b32 v59, 0
    v_mov_b32 v60, 0
    v_mov_b32 v61, 0
    v_mov_b32 v62, 0
    v_mov_b32 v63, 0
L_qok2:
    s_mov_b32 s46, 0
    s_mov_b32 s51, s49
L_pro:
    v_readlane_b32 s48, v3, s46
    s_mov_b32 m0, s51
    s_add_u32 s44, s51, 4352
    s_add_u32 s51, s51, 8576
    s_add_u32 s46, s46, 1
    s_nop 0
    buffer_load_dwordx4 v8, s[16:19], s48 offen offset:0 nt lds
    buffer_load_dwordx4 v9, s[16:19], s48 offen offset:1088 nt lds
    buffer_load_dwordx4 v10, s[16:19], s48 offen offset:2176 nt lds
    buffer_load_dwordx4 v11, s[16:19], s48 offen offset:3264 nt lds
    s_mov_b32 m0, s44
    s_cmp_lt_u32 s46, 2
    buffer_load_dwordx4 v12, s[20:23], s48 offen offset:0 nt lds
    buffer_load_dwordx4 v13, s[20:23], s48 offen offset:1056 nt lds
    buffer_load_dwordx4 v14, s[20:23], s48 offen offset:2112 nt lds
    buffer_load_dwordx4 v15, s[20:23], s48 offen offset:3168 nt lds
    s_cbranch_scc1 L_pro
    s_mov_b32 s46, 0
    s_mov_b32 s47, 0
    s_mov_b32 s50, 2
    s_branch L_qok
.section .rodata,"a"
.p2align 6
.amdhsa_kernel standalone__paged_block_table_kv_radixattention__decode_kernel
  .amdhsa_next_free_vgpr 128
  .amdhsa_next_free_sgpr 102
  .amdhsa_accum_offset 128
  .amdhsa_group_segment_fixed_size 0
  .amdhsa_kernarg_size 64
  .amdhsa_user_sgpr_count 2
  .amdhsa_user_sgpr_kernarg_segment_ptr 1
  .amdhsa_system_sgpr_workgroup_id_x 1
.end_amdhsa_kernel
```
